```python
import torch

def _softmax(x, axis=-1):
    return torch.softmax(x, dim=axis)
def _gelu(x):
    return torch.nn.functional.gelu(x, approximate="tanh")
def _silu(x):
    return torch.nn.functional.silu(x)
def _sigmoid(x):
    return torch.sigmoid(x)
def _layernorm(x, axis=-1, eps=1e-5):
    m = x.mean(dim=axis, keepdim=True)
    v = x.var(dim=axis, keepdim=True, unbiased=False)
    return (x - m) / torch.sqrt(v + eps)
def _scatter_add(tgt, idx, src, axis=0):
    return tgt.clone().index_add_(axis, idx, src)
def _segment_sum(src, seg, n):
    out = torch.zeros((n,) + src.shape[1:], dtype=src.dtype)
    return out.index_add_(0, seg, src)
def _pad(x, pw):
    flat = tuple(v for pair in reversed(pw) for v in pair)
    return torch.nn.functional.pad(x, flat)

kernel_name = 'gated_mix__sliding_block_cached__geglu_ffn__decode'

def setup_inputs():

    _w = (lambda a: (lambda t: t.to(torch.bfloat16) if t.is_floating_point() else t)(torch.as_tensor(a)))
    def _A_setup():
        B, Sq, D = 1, 1, 640
        Hq, Hkv, Sk, Dh = 32, 32, 32768, 192
        assert Hq % Hkv == 0, (Hq, Hkv)
        return {
            "x": _w((lambda *s: torch.randn(*s, dtype=torch.bfloat16) * 0.05)(B, Sq, D)),
            "k_cache": _w((lambda *s: torch.randn(*s, dtype=torch.bfloat16) * 6.4)(B, Hkv, Sk, Dh)),
            "v_cache": _w((lambda *s: torch.randn(*s, dtype=torch.bfloat16) * 0.2)(B, Hkv, Sk, Dh)),
            "wq": _w((lambda *s: torch.randn(*s, dtype=torch.bfloat16) * 6.4)(D, Hq * Dh) * (D ** -0.5)),
            "wo": _w((lambda *s: torch.randn(*s, dtype=torch.bfloat16) * 0.2)(Hq * Dh, D) * ((Hq * Dh) ** -0.5)),
        }
    _A_in = _A_setup()

    def _B_setup():
        B, S, D, F = 1, 1, 640, 1536
        return {
            "x": _w((lambda *s: torch.randn(*s, dtype=torch.bfloat16) * 0.05)(B, S, D)),
            "w_gate": _w((lambda *s: torch.randn(*s, dtype=torch.bfloat16) * 0.05)(D, F)),
            "w_up": _w((lambda *s: torch.randn(*s, dtype=torch.bfloat16) * 0.05)(D, F)),
            "w_down": _w((lambda *s: torch.randn(*s, dtype=torch.bfloat16) * 0.05)(F, D)),
        }
    _B_in = _B_setup()

    return {
        "A_x": _A_in["x"],
        "A_k_cache": _A_in["k_cache"],
        "A_v_cache": _A_in["v_cache"],
        "A_wq": _A_in["wq"],
        "A_wo": _A_in["wo"],
        "B_x": _B_in["x"],
        "B_w_gate": _B_in["w_gate"],
        "B_w_up": _B_in["w_up"],
        "B_w_down": _B_in["w_down"],
        "gate_w": _w((lambda *s: torch.randn(*s, dtype=torch.bfloat16) * 0.1)(640) * 16.0),
    }

def reference(A_x, A_k_cache, A_v_cache, A_wq, A_wo, B_x, B_w_gate, B_w_up, B_w_down, gate_w):
    def _A_ref(x, k_cache, v_cache, wq, wo):
        B, Sq, D = x.shape
        Hq, Dh = 32, 192
        Hkv, Sk = k_cache.shape[1], k_cache.shape[2]
        W = min(4096, max(256, Sk // 4))
        rep = Hq // Hkv
        q = (lambda x, *d: x.permute(*d))((x @ wq).reshape(B, Sq, Hq, Dh), 0, 2, 1, 3)
        k = (lambda x, n, axis: torch.repeat_interleave(x, n, dim=axis))(k_cache[:, :, Sk - W:, :], rep, axis=1)
        v = (lambda x, n, axis: torch.repeat_interleave(x, n, dim=axis))(v_cache[:, :, Sk - W:, :], rep, axis=1)
        scores = torch.einsum("bhqd,bhkd->bhqk", q, k) * (Dh ** -0.5)
        p = _softmax(scores, axis=-1)
        o = torch.einsum("bhqk,bhkd->bhqd", p, v)
        return (lambda x, *d: x.permute(*d))(o, 0, 2, 1, 3).reshape(B, Sq, Hq * Dh) @ wo

    def _B_ref(x, w_gate, w_up, w_down):
        return (_gelu(x @ w_gate) * (x @ w_up)) @ w_down

    x = A_x
    g = _sigmoid((x * gate_w).sum(-1, keepdims=True))
    a = _A_ref(x, A_k_cache, A_v_cache, A_wq, A_wo)
    b = _B_ref(x, B_w_gate, B_w_up, B_w_down)
    return g * a + (1 - g) * b
```

```asm
; @launch grid=(256,1,1) block=(512,1,1) lds=29376
.amdgcn_target "amdgcn-amd-amdhsa--gfx950"
.text
.globl gated_mix__sliding_block_cached__geglu_ffn__decode_kernel
.p2align 8
.type gated_mix__sliding_block_cached__geglu_ffn__decode_kernel,@function
gated_mix__sliding_block_cached__geglu_ffn__decode_kernel:
    s_load_dwordx16 s[4:19], s[0:1], 0
    s_lshr_b32 s31, s2, 5
    s_and_b32 s30, s2, 31
    s_cmpk_ge_u32 s2, 256
    s_cbranch_scc1 L_end
    v_lshrrev_b32 v7, 3, v0
    v_and_b32 v6, 7, v0
    v_mul_u32_u24 v1, 384, v7
    s_lshl_b32 s34, s30, 6
    s_add_u32 s34, s34, s31
    s_add_u32 s34, s34, 56
    s_mul_i32 s34, s34, 196608
    s_lshr_b32 s65, s2, 3
    s_add_u32 s65, s65, s2
    s_and_b32 s65, s65, 7
    s_mulk_i32 s65, 24576
    v_lshl_add_u32 v1, v6, 4, v1
    s_add_u32 s35, s34, s65
    s_waitcnt lgkmcnt(0)
    s_add_u32 s66, s6, s35
    s_addc_u32 s67, s7, 0
    global_load_dwordx4 v[160:163], v1, s[66:67] offset:0 nt
    global_load_dwordx4 v[164:167], v1, s[66:67] offset:128 nt
    global_load_dwordx4 v[168:171], v1, s[66:67] offset:256 nt
    s_load_dwordx8 s[20:27], s[0:1], 64
    s_load_dwordx2 s[28:29], s[0:1], 96
    s_add_u32 s36, s6, s34
    s_addc_u32 s37, s7, 0
    s_mov_b32 s38, 196608
    s_mov_b32 s39, 0x20000
    s_add_u32 s65, s65, 24576
    s_cmp_eq_u32 s65, 196608
    s_cselect_b32 s65, 0, s65
    buffer_load_dwordx4 v[172:175], v1, s[36:39], s65 offen offset:0 nt
    s_setprio 3
    v_lshrrev_b32 v2, 6, v0
    v_and_b32 v0, 63, v0
    v_mov_b32 v5, 0
    v_readfirstlane_b32 s32, v2
    v_lshlrev_b32 v63, 2, v2
    v_and_b32 v7, 7, v7
    ds_write2_b32 v63, v5, v5 offset0:0 offset1:8
    s_add_u32 s40, s8, s34
    s_addc_u32 s41, s9, 0
    s_mov_b32 s42, 196608
    s_mov_b32 s43, 0x20000
    s_mul_i32 s35, s31, 80
    s_mul_i32 s3, s32, 10
    s_add_u32 s35, s35, s3
    s_lshl_b32 s3, s35, 1
    s_add_u32 s66, s4, s3
    s_addc_u32 s67, s5, 0
    s_mul_i32 s34, s35, 12288
    s_mul_i32 s3, s30, 384
    s_add_u32 s34, s34, s3
    s_add_u32 s10, s10, s34
    s_addc_u32 s11, s11, 0
    s_cmp_lt_u32 s30, 16
    s_cselect_b32 s16, s16, s18
    s_cselect_b32 s17, s17, s19
    s_bitcmp1_b32 s30, 3
    s_cselect_b32 s3, 5, 0
    s_cselect_b32 s18, 0xffffff, -1
    s_cselect_b32 s19, 0, 0xffff
    s_add_u32 s3, s3, s35
    s_mul_i32 s34, s3, 3072
    s_and_b32 s3, s30, 7
    s_mul_i32 s3, s3, 384
    s_add_u32 s34, s34, s3
    s_add_u32 s16, s16, s34
    s_addc_u32 s17, s17, 0
    s_sub_u32 s16, s16, 384
    s_subb_u32 s17, s17, 0
    s_xor_b32 s68, s18, 0xff000000
    s_xor_b32 s69, s19, 0xffff
    v_mov_b32 v2, s10
    v_mov_b32 v3, s11
    v_mov_b32 v4, 12288
    v_mov_b32 v58, v0
    v_mov_b32 v59, 0
    s_mov_b32 exec_lo, 0xff000000
    v_mov_b32 v2, s16
    v_mov_b32 v3, s17
    v_mov_b32 v4, 3072
    s_mov_b32 exec_lo, -1
    v_lshl_add_u64 v[2:3], v[58:59], 4, v[2:3]
    s_mov_b64 exec, s[18:19]
    global_load_dwordx4 v[64:67], v[2:3], off nt
    v_lshl_add_u64 v[2:3], v[4:5], 0, v[2:3]
    global_load_dwordx4 v[68:71], v[2:3], off nt
    v_lshl_add_u64 v[2:3], v[4:5], 0, v[2:3]
    global_load_dwordx4 v[72:75], v[2:3], off nt
    v_lshl_add_u64 v[2:3], v[4:5], 0, v[2:3]
    s_waitcnt lgkmcnt(0)
    s_load_dwordx4 s[60:63], s[66:67], 0
    s_load_dword s64, s[66:67], 16
    s_load_dword s33, s[28:29], 0
    s_barrier
    s_getreg_b32 s14, hwreg(HW_REG_XCC_ID, 0, 4)
    s_and_b32 s3, s30, 7
    s_lshl_b32 s3, s3, 5
    s_add_u32 s26, s26, s3
    s_addc_u32 s27, s27, 0
    s_lshr_b32 s3, s2, 3
    v_mov_b32 v60, s3
    s_add_u32 s3, s14, 1
    v_mov_b32 v61, s3
    s_cmp_eq_u32 s32, 0
    s_cbranch_scc0 L_nohello
    s_mov_b64 exec, 1
    global_store_byte v60, v61, s[26:27]
L_nohello:
    s_mov_b64 exec, -1
    s_mul_i32 s3, s32, 160
    v_lshl_add_u32 v62, v0, 2, s3
    v_mov_b32 v24, 0
    v_mov_b32 v26, 0
    s_setprio 2
    s_mov_b32 exec_hi, 0xff
    global_load_dword v24, v62, s[4:5]
    global_load_dword v26, v62, s[22:23]
    s_mov_b64 exec, s[18:19]
    global_load_dwordx4 v[76:79], v[2:3], off nt
    v_lshl_add_u64 v[2:3], v[4:5], 0, v[2:3]
    global_load_dwordx4 v[80:83], v[2:3], off nt
    v_lshl_add_u64 v[2:3], v[4:5], 0, v[2:3]
    s_mov_b64 exec, s[68:69]
    global_load_dwordx4 v[84:87], v[2:3], off nt
    v_lshl_add_u64 v[2:3], v[4:5], 0, v[2:3]
    global_load_dwordx4 v[88:91], v[2:3], off nt
    v_lshl_add_u64 v[2:3], v[4:5], 0, v[2:3]
    s_setprio 1
    global_load_dwordx4 v[92:95], v[2:3], off nt
    v_lshl_add_u64 v[2:3], v[4:5], 0, v[2:3]
    global_load_dwordx4 v[96:99], v[2:3], off nt
    v_lshl_add_u64 v[2:3], v[4:5], 0, v[2:3]
    global_load_dwordx4 v[100:103], v[2:3], off nt
    s_mov_b64 exec, -1
    s_setprio 0
    s_mov_b32 s44, s12
    s_mov_b32 s45, s13
    s_mov_b32 s46, 7864320
    s_mov_b32 s47, 0x20000
    s_mov_b32 s48, s20
    s_mov_b32 s49, s21
    s_mov_b32 s50, 1966080
    s_mov_b32 s51, 0x20000
    s_mov_b32 s52, s28
    s_mov_b32 s53, s29
    s_mov_b32 s54, 587776
    s_mov_b32 s55, 0x20000
    s_mov_b32 s56, s24
    s_mov_b32 s57, s25
    s_mov_b32 s58, 1280
    s_mov_b32 s59, 0x20000
    s_mov_b32 s21, s14
    s_mov_b64 s[4:5], s[18:19]
    s_mov_b64 s[24:25], s[68:69]
    s_lshl_b32 s3, s30, 3
    s_add_u32 s34, s3, s31
    s_lshl_b32 s35, s32, 7
    s_lshl_b32 s6, s34, 11
    s_add_u32 s6, s6, s35
    s_add_u32 s6, s6, 4096
    s_lshl_b32 s8, s3, 11
    s_add_u32 s8, s8, s35
    s_add_u32 s8, s8, 4096
    s_lshl_b32 s11, s30, 10
    s_add_u32 s11, s11, 528384
    s_lshl_b32 s19, s31, 3
    s_add_u32 s19, s19, s32
    s_lshl_b32 s19, s19, 4
    s_add_u32 s10, s11, s19
    s_mov_b32 s12, s6
    s_mov_b32 s13, s8
    s_lshl_b32 s3, s31, 11
    s_add_u32 s14, s3, 561152
    s_lshl_b32 s3, s31, 7
    s_add_u32 s15, s3, 577536
    s_cmp_eq_u32 s32, 6
    s_cselect_b32 s7, 0, 0x80000000
    s_cmp_eq_u32 s30, s31
    s_cselect_b32 s7, s7, 0x80000000
    v_lshlrev_b32 v58, 3, v0
    v_or_b32 v58, s7, v58
    v_mov_b32 v52, 0
    v_mov_b32 v53, 0
    buffer_atomic_swap_x2 v[52:53], v58, s[52:55], s14 offen sc0 sc1
    s_mul_i32 s19, s31, 160
    s_mul_i32 s16, s30, 192
    s_lshl_b32 s3, s32, 3
    s_add_u32 s16, s16, s3
    s_mul_i32 s16, s16, 1280
    s_add_u32 s16, s16, s19
    s_and_b32 s17, s30, 7
    s_mul_i32 s17, s17, 192
    s_add_u32 s17, s17, s3
    s_lshr_b32 s3, s30, 3
    s_lshl_b32 s3, s3, 1
    s_add_u32 s17, s17, s3
    s_mul_i32 s17, s17, 1280
    s_add_u32 s17, s17, s19
    s_mov_b32 s68, 0x01010101
    s_mov_b32 s69, 0x01010101
    v_mov_b32 v58, 0xffff
    v_and_b32 v59, 1, v6
    v_lshlrev_b32 v59, 4, v59
    v_lshlrev_b32 v58, v59, v58
    v_lshrrev_b32 v59, 1, v6
    v_cmp_eq_u32 vcc, 0, v59
    v_mov_b32 v32, 0
    v_mov_b32 v33, 0
    v_cndmask_b32 v8, 0, v58, vcc
    v_cmp_eq_u32 vcc, 1, v59
    v_mov_b32 v34, 0
    v_mov_b32 v35, 0
    v_cndmask_b32 v9, 0, v58, vcc
    v_cmp_eq_u32 vcc, 2, v59
    v_mov_b32 v36, 0
    v_mov_b32 v37, 0
    v_cndmask_b32 v10, 0, v58, vcc
    v_cmp_eq_u32 vcc, 3, v59
    v_mov_b32 v38, 0
    v_mov_b32 v39, 0
    v_cndmask_b32 v11, 0, v58, vcc
    s_mul_i32 s3, s32, 1552
    v_lshl_add_u32 v12, v0, 5, s3
    v_mul_u32_u24 v15, 1552, v6
    v_lshl_add_u32 v13, v7, 2, v15
    s_mul_i32 s3, s32, 32
    s_add_u32 s3, s3, 832
    v_add_u32 v14, s3, v13
    s_mul_i32 s3, s32, 96
    s_add_u32 s3, s3, 64
    v_add_u32 v13, s3, v13
    v_lshlrev_b32 v7, 4, v7
    v_lshlrev_b32 v2, 2, v6
    v_mov_b32 v3, 1
    s_waitcnt lgkmcnt(0)
    s_mul_i32 s33, s33, 0x0019660d
    s_add_u32 s33, s33, 0x3c6ef35f
    s_mul_i32 s9, s33, 0x0019660d
    s_add_u32 s9, s9, 0x3c6ef35f
    s_and_b32 s66, s60, 0xffff
    s_lshl_b32 s67, s60, 16
    s_mov_b64 exec, s[4:5]
    s_waitcnt vmcnt(11)
    v_dot2c_f32_bf16 v32, s66, v64
    v_dot2c_f32_bf16 v33, s67, v64
    v_dot2c_f32_bf16 v34, s66, v65
    v_dot2c_f32_bf16 v35, s67, v65
    v_dot2c_f32_bf16 v36, s66, v66
    v_dot2c_f32_bf16 v37, s67, v66
    v_dot2c_f32_bf16 v38, s66, v67
    v_dot2c_f32_bf16 v39, s67, v67
    s_lshr_b32 s66, s60, 16
    s_and_b32 s67, s60, 0xffff0000
    s_waitcnt vmcnt(10)
    v_dot2c_f32_bf16 v32, s66, v68
    v_dot2c_f32_bf16 v33, s67, v68
    v_dot2c_f32_bf16 v34, s66, v69
    v_dot2c_f32_bf16 v35, s67, v69
    v_dot2c_f32_bf16 v36, s66, v70
    v_dot2c_f32_bf16 v37, s67, v70
    v_dot2c_f32_bf16 v38, s66, v71
    v_dot2c_f32_bf16 v39, s67, v71
    s_and_b32 s66, s61, 0xffff
    s_lshl_b32 s67, s61, 16
    s_waitcnt vmcnt(9)
    v_dot2c_f32_bf16 v32, s66, v72
    v_dot2c_f32_bf16 v33, s67, v72
    v_dot2c_f32_bf16 v34, s66, v73
    v_dot2c_f32_bf16 v35, s67, v73
    v_dot2c_f32_bf16 v36, s66, v74
    v_dot2c_f32_bf16 v37, s67, v74
    v_dot2c_f32_bf16 v38, s66, v75
    v_dot2c_f32_bf16 v39, s67, v75
    s_mov_b64 exec, -1
    s_waitcnt vmcnt(7)
    v_and_b32 v25, 0xffff0000, v24
    v_lshlrev_b32 v24, 16, v24
    v_and_b32 v27, 0xffff0000, v26
    v_lshlrev_b32 v26, 16, v26
    v_mul_f32 v24, v24, v26
    v_mul_f32 v25, v25, v27
    v_cvt_pk_bf16_f32 v24, v24, v25
    v_and_b32 v25, 0xffff0000, v24
    v_lshlrev_b32 v24, 16, v24
    v_add_f32 v24, v24, v25
    s_nop 1
    v_add_f32_dpp v24, v24, v24 quad_perm:[1,0,3,2] row_mask:0xf bank_mask:0xf
    s_nop 1
    v_add_f32_dpp v24, v24, v24 quad_perm:[2,3,0,1] row_mask:0xf bank_mask:0xf
    s_nop 1
    v_add_f32_dpp v24, v24, v24 row_half_mirror row_mask:0xf bank_mask:0xf
    s_nop 1
    v_add_f32_dpp v24, v24, v24 row_ror:8 row_mask:0xf bank_mask:0xf
    v_mov_b32 v25, v24
    s_nop 1
    v_permlane16_swap_b32 v24, v25
    v_add_f32 v24, v24, v25
    v_mov_b32 v25, v24
    s_nop 1
    v_permlane32_swap_b32 v24, v25
    v_add_f32 v24, v24, v25
    s_lshr_b32 s66, s61, 16
    s_and_b32 s67, s61, 0xffff0000
    s_mov_b64 exec, s[4:5]
    s_waitcnt vmcnt(6)
    v_dot2c_f32_bf16 v32, s66, v76
    v_dot2c_f32_bf16 v33, s67, v76
    v_dot2c_f32_bf16 v34, s66, v77
    v_dot2c_f32_bf16 v35, s67, v77
    v_dot2c_f32_bf16 v36, s66, v78
    v_dot2c_f32_bf16 v37, s67, v78
    v_dot2c_f32_bf16 v38, s66, v79
    v_dot2c_f32_bf16 v39, s67, v79
    s_mov_b64 exec, -1
    buffer_load_dwordx4 v[176:179], v1, s[36:39], s65 offen offset:128 nt
    s_and_b32 s66, s62, 0xffff
    s_lshl_b32 s67, s62, 16
    s_mov_b64 exec, s[4:5]
    s_waitcnt vmcnt(6)
    v_dot2c_f32_bf16 v32, s66, v80
    v_dot2c_f32_bf16 v33, s67, v80
    v_dot2c_f32_bf16 v34, s66, v81
    v_dot2c_f32_bf16 v35, s67, v81
    v_dot2c_f32_bf16 v36, s66, v82
    v_dot2c_f32_bf16 v37, s67, v82
    v_dot2c_f32_bf16 v38, s66, v83
    v_dot2c_f32_bf16 v39, s67, v83
    s_lshr_b32 s66, s62, 16
    s_and_b32 s67, s62, 0xffff0000
    s_mov_b64 exec, s[24:25]
    s_waitcnt vmcnt(5)
    v_dot2c_f32_bf16 v32, s66, v84
    v_dot2c_f32_bf16 v33, s67, v84
    v_dot2c_f32_bf16 v34, s66, v85
    v_dot2c_f32_bf16 v35, s67, v85
    v_dot2c_f32_bf16 v36, s66, v86
    v_dot2c_f32_bf16 v37, s67, v86
    v_dot2c_f32_bf16 v38, s66, v87
    v_dot2c_f32_bf16 v39, s67, v87
    s_and_b32 s66, s63, 0xffff
    s_lshl_b32 s67, s63, 16
    s_waitcnt vmcnt(4)
    v_dot2c_f32_bf16 v32, s66, v88
    v_dot2c_f32_bf16 v33, s67, v88
    v_dot2c_f32_bf16 v34, s66, v89
    v_dot2c_f32_bf16 v35, s67, v89
    v_dot2c_f32_bf16 v36, s66, v90
    v_dot2c_f32_bf16 v37, s67, v90
    v_dot2c_f32_bf16 v38, s66, v91
    v_dot2c_f32_bf16 v39, s67, v91
    s_mov_b64 exec, -1
    buffer_load_dwordx4 v[180:183], v1, s[36:39], s65 offen offset:256 nt
    s_lshr_b32 s66, s63, 16
    s_and_b32 s67, s63, 0xffff0000
    s_mov_b64 exec, s[24:25]
    s_waitcnt vmcnt(4)
    v_dot2c_f32_bf16 v32, s66, v92
    v_dot2c_f32_bf16 v33, s67, v92
    v_dot2c_f32_bf16 v34, s66, v93
    v_dot2c_f32_bf16 v35, s67, v93
    v_dot2c_f32_bf16 v36, s66, v94
    v_dot2c_f32_bf16 v37, s67, v94
    v_dot2c_f32_bf16 v38, s66, v95
    v_dot2c_f32_bf16 v39, s67, v95
    s_load_dwordx8 s[92:99], s[26:27], 0
    s_and_b32 s66, s64, 0xffff
    s_lshl_b32 s67, s64, 16
    s_waitcnt vmcnt(3)
    v_dot2c_f32_bf16 v32, s66, v96
    v_dot2c_f32_bf16 v33, s67, v96
    v_dot2c_f32_bf16 v34, s66, v97
    v_dot2c_f32_bf16 v35, s67, v97
    v_dot2c_f32_bf16 v36, s66, v98
    v_dot2c_f32_bf16 v37, s67, v98
    v_dot2c_f32_bf16 v38, s66, v99
    v_dot2c_f32_bf16 v39, s67, v99
    s_lshr_b32 s66, s64, 16
    s_and_b32 s67, s64, 0xffff0000
    s_waitcnt vmcnt(2)
    v_dot2c_f32_bf16 v32, s66, v100
    v_dot2c_f32_bf16 v33, s67, v100
    v_dot2c_f32_bf16 v34, s66, v101
    v_dot2c_f32_bf16 v35, s67, v101
    v_dot2c_f32_bf16 v36, s66, v102
    v_dot2c_f32_bf16 v37, s67, v102
    v_dot2c_f32_bf16 v38, s66, v103
    v_dot2c_f32_bf16 v39, s67, v103
    s_mov_b64 exec, -1
    s_add_u32 s65, s65, 24576
    s_cmp_eq_u32 s65, 196608
    s_cselect_b32 s65, 0, s65
    buffer_load_dwordx4 v[184:187], v1, s[36:39], s65 offen offset:0 nt
    s_mov_b32 exec_hi, 0xffff
    ds_write_b128 v12, v[32:35] offset:64
    ds_write_b128 v12, v[36:39] offset:80
    s_mov_b64 exec, 1
    ds_write_b32 v12, v24 offset:1600
    ds_write_b32 v63, v3 offset:0
    s_mov_b64 exec, -1
    s_waitcnt vmcnt(2)
    buffer_load_dwordx4 v[188:191], v1, s[36:39], s65 offen offset:128 nt
    s_waitcnt vmcnt(2)
    buffer_load_dwordx4 v[192:195], v1, s[36:39], s65 offen offset:256 nt
    s_mov_b32 s34, 1048576
L_f1_chk:
    ds_read_b32 v4, v2 offset:0
    ds_read2_b32 v[44:45], v13 offset1:8
    ds_read_b32 v46, v13 offset:64
    ds_read2st64_b32 v[48:49], v14 offset1:1
    ds_read_b32 v50, v14 offset:512
    ds_read_b32 v24, v15 offset:1600
    s_sub_u32 s34, s34, 1
    s_waitcnt lgkmcnt(0)
    s_cbranch_scc1 L_f1_ok
    v_cmp_ne_u32 vcc, 1, v4
    s_cbranch_vccnz L_f1_chk
L_f1_ok:
    v_mov_b32 v47, s33
    v_mov_b32 v51, s33
    v_add_f32_dpp v44, v44, v44 quad_perm:[1,0,3,2] row_mask:0xf bank_mask:0xf
    v_add_f32_dpp v45, v45, v45 quad_perm:[1,0,3,2] row_mask:0xf bank_mask:0xf
    v_add_f32_dpp v46, v46, v46 quad_perm:[1,0,3,2] row_mask:0xf bank_mask:0xf
    v_add_f32_dpp v48, v48, v48 quad_perm:[1,0,3,2] row_mask:0xf bank_mask:0xf
    v_add_f32_dpp v49, v49, v49 quad_perm:[1,0,3,2] row_mask:0xf bank_mask:0xf
    v_add_f32_dpp v50, v50, v50 quad_perm:[1,0,3,2] row_mask:0xf bank_mask:0xf
    v_add_f32_dpp v24, v24, v24 quad_perm:[1,0,3,2] row_mask:0xf bank_mask:0xf
    v_add_f32_dpp v44, v44, v44 quad_perm:[2,3,0,1] row_mask:0xf bank_mask:0xf
    v_add_f32_dpp v45, v45, v45 quad_perm:[2,3,0,1] row_mask:0xf bank_mask:0xf
    v_add_f32_dpp v46, v46, v46 quad_perm:[2,3,0,1] row_mask:0xf bank_mask:0xf
    v_add_f32_dpp v48, v48, v48 quad_perm:[2,3,0,1] row_mask:0xf bank_mask:0xf
    v_add_f32_dpp v49, v49, v49 quad_perm:[2,3,0,1] row_mask:0xf bank_mask:0xf
    v_add_f32_dpp v50, v50, v50 quad_perm:[2,3,0,1] row_mask:0xf bank_mask:0xf
    v_add_f32_dpp v24, v24, v24 quad_perm:[2,3,0,1] row_mask:0xf bank_mask:0xf
    v_add_f32_dpp v44, v44, v44 row_half_mirror row_mask:0xf bank_mask:0xf
    v_add_f32_dpp v45, v45, v45 row_half_mirror row_mask:0xf bank_mask:0xf
    v_add_f32_dpp v46, v46, v46 row_half_mirror row_mask:0xf bank_mask:0xf
    v_add_f32_dpp v48, v48, v48 row_half_mirror row_mask:0xf bank_mask:0xf
    v_add_f32_dpp v49, v49, v49 row_half_mirror row_mask:0xf bank_mask:0xf
    v_add_f32_dpp v50, v50, v50 row_half_mirror row_mask:0xf bank_mask:0xf
    v_add_f32_dpp v24, v24, v24 row_half_mirror row_mask:0xf bank_mask:0xf
    s_add_u32 s65, s65, 24576
    s_cmp_eq_u32 s65, 196608
    s_cselect_b32 s65, 0, s65
    s_waitcnt vmcnt(2)
    buffer_load_dwordx4 v[196:199], v1, s[36:39], s65 offen offset:0 nt
    s_add_u32 s3, s21, 1
    s_mul_i32 s3, s3, 0x01010101
    s_mov_b32 s20, 1
    s_cmp_eq_u32 s92, s3
    s_cselect_b32 s20, s20, 0
    s_cmp_eq_u32 s93, s3
    s_cselect_b32 s20, s20, 0
    s_cmp_eq_u32 s94, s3
    s_cselect_b32 s20, s20, 0
    s_cmp_eq_u32 s95, s3
    s_cselect_b32 s20, s20, 0
    s_cmp_eq_u32 s96, s3
    s_cselect_b32 s20, s20, 0
    s_cmp_eq_u32 s97, s3
    s_cselect_b32 s20, s20, 0
    s_cmp_eq_u32 s98, s3
    s_cselect_b32 s20, s20, 0
    s_cmp_eq_u32 s99, s3
    s_cselect_b32 s20, s20, 0
    s_mov_b64 exec, s[68:69]
    s_cmp_eq_u32 s20, 1
    s_cbranch_scc1 L_p0_loc
    buffer_store_dwordx4 v[44:47], v7, s[52:55], s6 offen sc1
    buffer_store_dwordx4 v[48:51], v7, s[52:55], s6 offen offset:1024 sc1
    s_branch L_p0_pub
L_p0_loc:
    buffer_store_dwordx4 v[44:47], v7, s[52:55], s6 offen
    buffer_store_dwordx4 v[48:51], v7, s[52:55], s6 offen offset:1024
L_p0_pub:
    s_cmp_eq_u32 s7, 0
    s_cbranch_scc0 L_nozero
    buffer_store_dwordx4 v[44:47], v7, s[52:55], s15 offen sc1
L_nozero:
    s_mov_b64 exec, -1
    buffer_load_dwordx4 v[200:203], v1, s[36:39], s65 offen offset:128 nt
    buffer_load_dwordx4 v[204:207], v1, s[36:39], s65 offen offset:256 nt
    v_cvt_pk_bf16_f32 v24, v24, v24
    v_and_b32 v24, 0xffff0000, v24
    v_mul_f32 v24, 0xbfb8aa3b, v24
    v_exp_f32 v24, v24
    s_nop 0
    v_add_f32 v24, 1.0, v24
    v_rcp_f32 v24, v24
    s_nop 0
    v_cvt_pk_bf16_f32 v56, v24, v24
    v_and_b32 v56, 0xffff0000, v56
    v_lshl_add_u32 v58, v6, 11, v7
    s_mul_i32 s3, s32, 48
    s_add_u32 s3, s3, 12480
    v_lshrrev_b32 v60, 3, v7
    v_add_u32 v60, s3, v60
    v_lshlrev_b32 v61, 4, v6
    v_mov_b32 v24, 0
    v_mov_b32 v25, 0
    v_mov_b32 v26, 0
    v_mov_b32 v27, 0
    v_mov_b32 v28, 0
    v_mov_b32 v29, 0
    v_mov_b32 v30, 0
    v_mov_b32 v31, 0
    s_add_u32 s65, s65, 24576
    s_cmp_eq_u32 s65, 196608
    s_cselect_b32 s65, 0, s65
    s_waitcnt vmcnt(2)
    buffer_load_dwordx4 v[208:211], v1, s[36:39], s65 offen offset:0 nt
    s_waitcnt vmcnt(2)
    buffer_load_dwordx4 v[212:215], v1, s[36:39], s65 offen offset:128 nt
    s_waitcnt vmcnt(2)
    buffer_load_dwordx4 v[216:219], v1, s[36:39], s65 offen offset:256 nt
    s_add_u32 s65, s65, 24576
    s_cmp_eq_u32 s65, 196608
    s_cselect_b32 s65, 0, s65
    s_waitcnt vmcnt(2)
    buffer_load_dwordx4 v[220:223], v1, s[36:39], s65 offen offset:0 nt
    s_cmp_eq_u32 s32, s31
    s_cselect_b32 s4, 0, 0x80000000
    s_cmp_ge_u32 s30, 24
    s_cselect_b32 s4, s4, 0x80000000
    v_or_b32 v59, s4, v58
    s_and_b32 s3, s30, 7
    s_lshl_b32 s22, s3, 10
    s_lshl_b32 s3, s3, 14
    s_lshl_b32 s5, s32, 7
    s_add_u32 s22, s22, s5
    s_add_u32 s22, s22, 579584
    s_add_u32 s5, s5, s3
    s_add_u32 s5, s5, 5120
    s_add_u32 s23, s5, 131072
    s_add_u32 s24, s23, 131072
    s_add_u32 s25, s24, 131072
    buffer_load_dwordx4 v[44:47], v58, s[52:55], s8 offen sc1
    buffer_load_dwordx4 v[144:147], v59, s[52:55], s5 offen sc1
    buffer_load_dwordx4 v[148:151], v59, s[52:55], s23 offen sc1
    buffer_load_dwordx4 v[152:155], v59, s[52:55], s24 offen sc1
    buffer_load_dwordx4 v[156:159], v59, s[52:55], s25 offen sc1
    s_waitcnt vmcnt(7)
    buffer_load_dwordx4 v[224:227], v1, s[36:39], s65 offen offset:128 nt
    s_waitcnt vmcnt(7)
    buffer_load_dwordx4 v[228:231], v1, s[36:39], s65 offen offset:256 nt
    s_add_u32 s65, s65, 24576
    s_cmp_eq_u32 s65, 196608
    s_cselect_b32 s65, 0, s65
    s_waitcnt vmcnt(7)
    buffer_load_dwordx4 v[232:235], v1, s[36:39], s65 offen offset:0 nt
    s_waitcnt vmcnt(2)
    buffer_load_dwordx4 v[236:239], v1, s[36:39], s65 offen offset:128 nt
    s_mov_b32 s34, 1048576
L_h0_chk:
    v_cmp_ne_u32 vcc, s33, v47
    s_cbranch_vccz L_h0_ok
    s_mov_b64 exec, vcc
    buffer_load_dwordx4 v[44:47], v58, s[52:55], s8 offen sc1
    s_sub_u32 s34, s34, 1
    s_waitcnt vmcnt(0)
    s_cbranch_scc0 L_h0_chk
L_h0_ok:
    s_mov_b64 exec, -1
    v_add_f32_dpp v44, v44, v44 quad_perm:[1,0,3,2] row_mask:0xf bank_mask:0xf
    v_add_f32_dpp v45, v45, v45 quad_perm:[1,0,3,2] row_mask:0xf bank_mask:0xf
    v_add_f32_dpp v46, v46, v46 quad_perm:[1,0,3,2] row_mask:0xf bank_mask:0xf
    v_add_f32_dpp v44, v44, v44 quad_perm:[2,3,0,1] row_mask:0xf bank_mask:0xf
    v_add_f32_dpp v45, v45, v45 quad_perm:[2,3,0,1] row_mask:0xf bank_mask:0xf
    v_add_f32_dpp v46, v46, v46 quad_perm:[2,3,0,1] row_mask:0xf bank_mask:0xf
    v_add_f32_dpp v44, v44, v44 row_half_mirror row_mask:0xf bank_mask:0xf
    v_add_f32_dpp v45, v45, v45 row_half_mirror row_mask:0xf bank_mask:0xf
    v_add_f32_dpp v46, v46, v46 row_half_mirror row_mask:0xf bank_mask:0xf
    v_cvt_pk_bf16_f32 v44, v44, v45
    v_cvt_pk_bf16_f32 v46, v46, v46
    s_mov_b64 exec, s[68:69]
    ds_write_b16 v60, v44
    ds_write_b16_d16_hi v60, v44 offset:16
    ds_write_b16 v60, v46 offset:32
    s_mov_b64 exec, 1
    ds_write_b32 v63, v3 offset:32
    s_mov_b64 exec, -1
    s_cmp_eq_u32 s4, 0
    s_cbranch_scc0 L_nohid
    s_mov_b32 s34, 1048576
L_hf_chk:
    v_cmp_ne_u32 vcc, s33, v147
    v_cmp_ne_u32 s[66:67], s33, v151
    s_or_b64 vcc, vcc, s[66:67]
    v_cmp_ne_u32 s[66:67], s33, v155
    s_or_b64 vcc, vcc, s[66:67]
    v_cmp_ne_u32 s[66:67], s33, v159
    s_or_b64 vcc, vcc, s[66:67]
    s_cbranch_vccz L_hf_ok
    s_mov_b64 exec, vcc
    buffer_load_dwordx4 v[144:147], v59, s[52:55], s5 offen sc1
    buffer_load_dwordx4 v[148:151], v59, s[52:55], s23 offen sc1
    buffer_load_dwordx4 v[152:155], v59, s[52:55], s24 offen sc1
    buffer_load_dwordx4 v[156:159], v59, s[52:55], s25 offen sc1
    s_sub_u32 s34, s34, 1
    s_waitcnt vmcnt(0)
    s_cbranch_scc0 L_hf_chk
L_hf_ok:
    s_mov_b64 exec, -1
    v_add_f32 v144, v144, v148
    v_add_f32 v152, v152, v156
    v_add_f32 v145, v145, v149
    v_add_f32 v153, v153, v157
    v_add_f32 v146, v146, v150
    v_add_f32 v154, v154, v158
    v_add_f32_dpp v144, v144, v144 quad_perm:[1,0,3,2] row_mask:0xf bank_mask:0xf
    v_add_f32_dpp v145, v145, v145 quad_perm:[1,0,3,2] row_mask:0xf bank_mask:0xf
    v_add_f32_dpp v146, v146, v146 quad_perm:[1,0,3,2] row_mask:0xf bank_mask:0xf
    v_add_f32_dpp v152, v152, v152 quad_perm:[1,0,3,2] row_mask:0xf bank_mask:0xf
    v_add_f32_dpp v153, v153, v153 quad_perm:[1,0,3,2] row_mask:0xf bank_mask:0xf
    v_add_f32_dpp v154, v154, v154 quad_perm:[1,0,3,2] row_mask:0xf bank_mask:0xf
    v_add_f32_dpp v144, v144, v144 quad_perm:[2,3,0,1] row_mask:0xf bank_mask:0xf
    v_add_f32_dpp v145, v145, v145 quad_perm:[2,3,0,1] row_mask:0xf bank_mask:0xf
    v_add_f32_dpp v146, v146, v146 quad_perm:[2,3,0,1] row_mask:0xf bank_mask:0xf
    v_add_f32_dpp v152, v152, v152 quad_perm:[2,3,0,1] row_mask:0xf bank_mask:0xf
    v_add_f32_dpp v153, v153, v153 quad_perm:[2,3,0,1] row_mask:0xf bank_mask:0xf
    v_add_f32_dpp v154, v154, v154 quad_perm:[2,3,0,1] row_mask:0xf bank_mask:0xf
    v_add_f32_dpp v144, v144, v144 row_half_mirror row_mask:0xf bank_mask:0xf
    v_add_f32_dpp v145, v145, v145 row_half_mirror row_mask:0xf bank_mask:0xf
    v_add_f32_dpp v146, v146, v146 row_half_mirror row_mask:0xf bank_mask:0xf
    v_add_f32_dpp v152, v152, v152 row_half_mirror row_mask:0xf bank_mask:0xf
    v_add_f32_dpp v153, v153, v153 row_half_mirror row_mask:0xf bank_mask:0xf
    v_add_f32_dpp v154, v154, v154 row_half_mirror row_mask:0xf bank_mask:0xf
    v_cvt_pk_bf16_f32 v144, v144, v144
    v_cvt_pk_bf16_f32 v145, v145, v145
    v_cvt_pk_bf16_f32 v146, v146, v146
    v_cvt_pk_bf16_f32 v152, v152, v152
    v_cvt_pk_bf16_f32 v153, v153, v153
    v_cvt_pk_bf16_f32 v154, v154, v154
    v_and_b32 v144, 0xffff0000, v144
    v_and_b32 v145, 0xffff0000, v145
    v_and_b32 v146, 0xffff0000, v146
    v_and_b32 v152, 0xffff0000, v152
    v_and_b32 v153, 0xffff0000, v153
    v_and_b32 v154, 0xffff0000, v154
    s_mov_b32 s3, 0x3d372713
    v_mul_f32 v148, v144, v144
    v_mul_f32 v149, v145, v145
    v_mul_f32 v150, v146, v146
    v_fma_f32 v148, v148, s3, 1.0
    v_fma_f32 v149, v149, s3, 1.0
    v_fma_f32 v150, v150, s3, 1.0
    v_mul_f32 v148, v148, v144
    v_mul_f32 v149, v149, v145
    v_mul_f32 v150, v150, v146
    v_mul_f32 v148, 0xc0135761, v148
    v_mul_f32 v149, 0xc0135761, v149
    v_mul_f32 v150, 0xc0135761, v150
    v_exp_f32 v148, v148
    v_exp_f32 v149, v149
    v_exp_f32 v150, v150
    v_add_f32 v148, 1.0, v148
    v_add_f32 v149, 1.0, v149
    v_add_f32 v150, 1.0, v150
    v_rcp_f32 v148, v148
    v_rcp_f32 v149, v149
    v_rcp_f32 v150, v150
    v_mul_f32 v148, v148, v144
    v_mul_f32 v149, v149, v145
    v_mul_f32 v150, v150, v146
    v_cvt_pk_bf16_f32 v148, v148, v148
    v_cvt_pk_bf16_f32 v149, v149, v149
    v_cvt_pk_bf16_f32 v150, v150, v150
    v_and_b32 v148, 0xffff0000, v148
    v_and_b32 v149, 0xffff0000, v149
    v_and_b32 v150, 0xffff0000, v150
    v_mul_f32 v148, v148, v152
    v_mul_f32 v149, v149, v153
    v_mul_f32 v150, v150, v154
    v_cvt_pk_bf16_f32 v148, v148, v148
    v_cvt_pk_bf16_f32 v149, v149, v149
    v_cvt_pk_bf16_f32 v150, v150, v150
    s_mov_b64 exec, s[68:69]
    s_cmp_eq_u32 s20, 1
    s_cbranch_scc1 L_pf_loc
    buffer_store_dwordx4 v[148:151], v7, s[52:55], s22 offen sc1
    s_branch L_pf_pub
L_pf_loc:
    buffer_store_dwordx4 v[148:151], v7, s[52:55], s22 offen
L_pf_pub:
    s_mov_b64 exec, -1
L_nohid:
    s_waitcnt vmcnt(2)
    buffer_load_dwordx4 v[240:243], v1, s[36:39], s65 offen offset:256 nt
    s_add_u32 s65, s65, 24576
    s_cmp_eq_u32 s65, 196608
    s_cselect_b32 s65, 0, s65
    s_waitcnt vmcnt(2)
    buffer_load_dwordx4 v[244:247], v1, s[36:39], s65 offen offset:0 nt
    s_waitcnt vmcnt(2)
    buffer_load_dwordx4 v[248:251], v1, s[36:39], s65 offen offset:128 nt
    s_mov_b32 s34, 1048576
L_f2_chk:
    ds_read_b32 v4, v2 offset:32
    ds_read_b128 v[12:15], v61 offset:12480
    ds_read_b128 v[16:19], v61 offset:12608
    ds_read_b128 v[20:23], v61 offset:12736
    s_sub_u32 s34, s34, 1
    s_waitcnt lgkmcnt(0)
    s_cbranch_scc1 L_f2_ok
    v_cmp_ne_u32 vcc, 1, v4
    s_cbranch_vccnz L_f2_chk
L_f2_ok:
    v_dot2c_f32_bf16 v24, v160, v12
    v_dot2c_f32_bf16 v24, v161, v13
    v_dot2c_f32_bf16 v24, v162, v14
    v_dot2c_f32_bf16 v24, v163, v15
    v_dot2c_f32_bf16 v24, v164, v16
    v_dot2c_f32_bf16 v24, v165, v17
    v_dot2c_f32_bf16 v24, v166, v18
    v_dot2c_f32_bf16 v24, v167, v19
    v_dot2c_f32_bf16 v24, v168, v20
    v_dot2c_f32_bf16 v24, v169, v21
    v_dot2c_f32_bf16 v24, v170, v22
    v_dot2c_f32_bf16 v24, v171, v23
    v_dot2c_f32_bf16 v25, v172, v12
    v_dot2c_f32_bf16 v25, v173, v13
    v_dot2c_f32_bf16 v25, v174, v14
    v_dot2c_f32_bf16 v25, v175, v15
    v_dot2c_f32_bf16 v25, v176, v16
    v_dot2c_f32_bf16 v25, v177, v17
    v_dot2c_f32_bf16 v25, v178, v18
    v_dot2c_f32_bf16 v25, v179, v19
    v_dot2c_f32_bf16 v25, v180, v20
    v_dot2c_f32_bf16 v25, v181, v21
    v_dot2c_f32_bf16 v25, v182, v22
    v_dot2c_f32_bf16 v25, v183, v23
    s_waitcnt vmcnt(2)
    buffer_load_dwordx4 v[252:255], v1, s[36:39], s65 offen offset:256 nt
    v_dot2c_f32_bf16 v26, v184, v12
    v_dot2c_f32_bf16 v26, v185, v13
    v_dot2c_f32_bf16 v26, v186, v14
    v_dot2c_f32_bf16 v26, v187, v15
    v_dot2c_f32_bf16 v26, v188, v16
    v_dot2c_f32_bf16 v26, v189, v17
    v_dot2c_f32_bf16 v26, v190, v18
    v_dot2c_f32_bf16 v26, v191, v19
    v_dot2c_f32_bf16 v26, v192, v20
    v_dot2c_f32_bf16 v26, v193, v21
    v_dot2c_f32_bf16 v26, v194, v22
    v_dot2c_f32_bf16 v26, v195, v23
    v_dot2c_f32_bf16 v27, v196, v12
    v_dot2c_f32_bf16 v27, v197, v13
    v_dot2c_f32_bf16 v27, v198, v14
    v_dot2c_f32_bf16 v27, v199, v15
    v_dot2c_f32_bf16 v27, v200, v16
    v_dot2c_f32_bf16 v27, v201, v17
    v_dot2c_f32_bf16 v27, v202, v18
    v_dot2c_f32_bf16 v27, v203, v19
    v_dot2c_f32_bf16 v27, v204, v20
    v_dot2c_f32_bf16 v27, v205, v21
    v_dot2c_f32_bf16 v27, v206, v22
    v_dot2c_f32_bf16 v27, v207, v23
    s_add_u32 s65, s65, 24576
    s_cmp_eq_u32 s65, 196608
    s_cselect_b32 s65, 0, s65
    s_waitcnt vmcnt(2)
    buffer_load_dwordx4 v[104:107], v1, s[40:43], s65 offen offset:0 nt
    v_dot2c_f32_bf16 v28, v208, v12
    v_dot2c_f32_bf16 v28, v209, v13
    v_dot2c_f32_bf16 v28, v210, v14
    v_dot2c_f32_bf16 v28, v211, v15
    v_dot2c_f32_bf16 v28, v212, v16
    v_dot2c_f32_bf16 v28, v213, v17
    v_dot2c_f32_bf16 v28, v214, v18
    v_dot2c_f32_bf16 v28, v215, v19
    v_dot2c_f32_bf16 v28, v216, v20
    v_dot2c_f32_bf16 v28, v217, v21
    v_dot2c_f32_bf16 v28, v218, v22
    v_dot2c_f32_bf16 v28, v219, v23
    v_dot2c_f32_bf16 v29, v220, v12
    v_dot2c_f32_bf16 v29, v221, v13
    v_dot2c_f32_bf16 v29, v222, v14
    v_dot2c_f32_bf16 v29, v223, v15
    v_dot2c_f32_bf16 v29, v224, v16
    v_dot2c_f32_bf16 v29, v225, v17
    v_dot2c_f32_bf16 v29, v226, v18
    v_dot2c_f32_bf16 v29, v227, v19
    v_dot2c_f32_bf16 v29, v228, v20
    v_dot2c_f32_bf16 v29, v229, v21
    v_dot2c_f32_bf16 v29, v230, v22
    v_dot2c_f32_bf16 v29, v231, v23
    s_waitcnt vmcnt(2)
    buffer_load_dwordx4 v[108:111], v1, s[40:43], s65 offen offset:128 nt
    v_dot2c_f32_bf16 v30, v232, v12
    v_dot2c_f32_bf16 v30, v233, v13
    v_dot2c_f32_bf16 v30, v234, v14
    v_dot2c_f32_bf16 v30, v235, v15
    v_dot2c_f32_bf16 v30, v236, v16
    v_dot2c_f32_bf16 v30, v237, v17
    v_dot2c_f32_bf16 v30, v238, v18
    v_dot2c_f32_bf16 v30, v239, v19
    v_dot2c_f32_bf16 v30, v240, v20
    v_dot2c_f32_bf16 v30, v241, v21
    v_dot2c_f32_bf16 v30, v242, v22
    v_dot2c_f32_bf16 v30, v243, v23
    s_waitcnt vmcnt(2)
    buffer_load_dwordx4 v[112:115], v1, s[40:43], s65 offen offset:256 nt
    v_dot2c_f32_bf16 v31, v244, v12
    v_dot2c_f32_bf16 v31, v245, v13
    v_dot2c_f32_bf16 v31, v246, v14
    v_dot2c_f32_bf16 v31, v247, v15
    v_dot2c_f32_bf16 v31, v248, v16
    v_dot2c_f32_bf16 v31, v249, v17
    v_dot2c_f32_bf16 v31, v250, v18
    v_dot2c_f32_bf16 v31, v251, v19
    v_dot2c_f32_bf16 v31, v252, v20
    v_dot2c_f32_bf16 v31, v253, v21
    v_dot2c_f32_bf16 v31, v254, v22
    v_dot2c_f32_bf16 v31, v255, v23
    s_add_u32 s65, s65, 24576
    s_cmp_eq_u32 s65, 196608
    s_cselect_b32 s65, 0, s65
    s_waitcnt vmcnt(2)
    buffer_load_dwordx4 v[116:119], v1, s[40:43], s65 offen offset:0 nt
    v_add_f32_dpp v24, v24, v24 quad_perm:[1,0,3,2] row_mask:0xf bank_mask:0xf
    v_add_f32_dpp v25, v25, v25 quad_perm:[1,0,3,2] row_mask:0xf bank_mask:0xf
    v_add_f32_dpp v26, v26, v26 quad_perm:[1,0,3,2] row_mask:0xf bank_mask:0xf
    v_add_f32_dpp v27, v27, v27 quad_perm:[1,0,3,2] row_mask:0xf bank_mask:0xf
    v_add_f32_dpp v28, v28, v28 quad_perm:[1,0,3,2] row_mask:0xf bank_mask:0xf
    v_add_f32_dpp v29, v29, v29 quad_perm:[1,0,3,2] row_mask:0xf bank_mask:0xf
    v_add_f32_dpp v30, v30, v30 quad_perm:[1,0,3,2] row_mask:0xf bank_mask:0xf
    v_add_f32_dpp v31, v31, v31 quad_perm:[1,0,3,2] row_mask:0xf bank_mask:0xf
    v_add_f32_dpp v24, v24, v24 quad_perm:[2,3,0,1] row_mask:0xf bank_mask:0xf
    v_add_f32_dpp v25, v25, v25 quad_perm:[2,3,0,1] row_mask:0xf bank_mask:0xf
    v_add_f32_dpp v26, v26, v26 quad_perm:[2,3,0,1] row_mask:0xf bank_mask:0xf
    v_add_f32_dpp v27, v27, v27 quad_perm:[2,3,0,1] row_mask:0xf bank_mask:0xf
    v_add_f32_dpp v28, v28, v28 quad_perm:[2,3,0,1] row_mask:0xf bank_mask:0xf
    v_add_f32_dpp v29, v29, v29 quad_perm:[2,3,0,1] row_mask:0xf bank_mask:0xf
    v_add_f32_dpp v30, v30, v30 quad_perm:[2,3,0,1] row_mask:0xf bank_mask:0xf
    v_add_f32_dpp v31, v31, v31 quad_perm:[2,3,0,1] row_mask:0xf bank_mask:0xf
    v_add_f32_dpp v24, v24, v24 row_half_mirror row_mask:0xf bank_mask:0xf
    v_add_f32_dpp v25, v25, v25 row_half_mirror row_mask:0xf bank_mask:0xf
    v_add_f32_dpp v26, v26, v26 row_half_mirror row_mask:0xf bank_mask:0xf
    v_add_f32_dpp v27, v27, v27 row_half_mirror row_mask:0xf bank_mask:0xf
    v_add_f32_dpp v28, v28, v28 row_half_mirror row_mask:0xf bank_mask:0xf
    v_add_f32_dpp v29, v29, v29 row_half_mirror row_mask:0xf bank_mask:0xf
    v_add_f32_dpp v30, v30, v30 row_half_mirror row_mask:0xf bank_mask:0xf
    v_add_f32_dpp v31, v31, v31 row_half_mirror row_mask:0xf bank_mask:0xf
    v_cvt_pk_bf16_f32 v24, v24, v25
    v_cvt_pk_bf16_f32 v26, v26, v27
    v_cvt_pk_bf16_f32 v28, v28, v29
    v_cvt_pk_bf16_f32 v30, v30, v31
    v_and_b32 v25, 0xffff0000, v24
    v_lshlrev_b32 v24, 16, v24
    v_and_b32 v27, 0xffff0000, v26
    v_lshlrev_b32 v26, 16, v26
    v_and_b32 v29, 0xffff0000, v28
    v_lshlrev_b32 v28, 16, v28
    v_and_b32 v31, 0xffff0000, v30
    v_lshlrev_b32 v30, 16, v30
    v_mul_f32 v24, 0x3d93cd3a, v24
    v_mul_f32 v25, 0x3d93cd3a, v25
    v_mul_f32 v26, 0x3d93cd3a, v26
    v_mul_f32 v27, 0x3d93cd3a, v27
    v_mul_f32 v28, 0x3d93cd3a, v28
    v_mul_f32 v29, 0x3d93cd3a, v29
    v_mul_f32 v30, 0x3d93cd3a, v30
    v_mul_f32 v31, 0x3d93cd3a, v31
    v_cvt_pk_bf16_f32 v24, v24, v25
    v_cvt_pk_bf16_f32 v26, v26, v27
    v_cvt_pk_bf16_f32 v28, v28, v29
    v_cvt_pk_bf16_f32 v30, v30, v31
    v_and_b32 v25, 0xffff0000, v24
    v_lshlrev_b32 v24, 16, v24
    v_and_b32 v27, 0xffff0000, v26
    v_lshlrev_b32 v26, 16, v26
    v_and_b32 v29, 0xffff0000, v28
    v_lshlrev_b32 v28, 16, v28
    v_and_b32 v31, 0xffff0000, v30
    v_lshlrev_b32 v30, 16, v30
    s_waitcnt vmcnt(2)
    buffer_load_dwordx4 v[120:123], v1, s[40:43], s65 offen offset:128 nt
    v_max3_f32 v44, v24, v25, v26
    v_max3_f32 v45, v27, v28, v29
    v_max3_f32 v44, v44, v30, v31
    v_max_f32 v44, v44, v45
    s_nop 1
    v_max_f32_dpp v44, v44, v44 row_ror:8 row_mask:0xf bank_mask:0xf
    v_mov_b32 v45, v44
    s_nop 1
    v_permlane16_swap_b32 v44, v45
    v_max_f32 v44, v44, v45
    v_mov_b32 v45, v44
    s_nop 1
    v_permlane32_swap_b32 v44, v45
    v_max_f32 v44, v44, v45
    v_sub_f32 v24, v24, v44
    v_sub_f32 v25, v25, v44
    v_sub_f32 v26, v26, v44
    v_sub_f32 v27, v27, v44
    v_sub_f32 v28, v28, v44
    v_sub_f32 v29, v29, v44
    v_sub_f32 v30, v30, v44
    v_sub_f32 v31, v31, v44
    v_mul_f32 v24, 0x3fb8aa3b, v24
    v_mul_f32 v25, 0x3fb8aa3b, v25
    v_mul_f32 v26, 0x3fb8aa3b, v26
    v_mul_f32 v27, 0x3fb8aa3b, v27
    v_mul_f32 v28, 0x3fb8aa3b, v28
    v_mul_f32 v29, 0x3fb8aa3b, v29
    v_mul_f32 v30, 0x3fb8aa3b, v30
    v_mul_f32 v31, 0x3fb8aa3b, v31
    v_exp_f32 v24, v24
    v_exp_f32 v25, v25
    v_exp_f32 v26, v26
    v_exp_f32 v27, v27
    v_exp_f32 v28, v28
    v_exp_f32 v29, v29
    v_exp_f32 v30, v30
    v_exp_f32 v31, v31
    v_add_f32 v45, v24, v25
    v_add_f32 v46, v26, v27
    v_add_f32 v47, v28, v29
    v_add_f32 v48, v30, v31
    v_add_f32 v45, v45, v46
    v_add_f32 v48, v48, v47
    v_add_f32 v45, v45, v48
    s_nop 1
    v_add_f32_dpp v45, v45, v45 row_ror:8 row_mask:0xf bank_mask:0xf
    v_mov_b32 v48, v45
    s_nop 1
    v_permlane16_swap_b32 v45, v48
    v_add_f32 v45, v45, v48
    v_mov_b32 v48, v45
    s_nop 1
    v_permlane32_swap_b32 v45, v48
    v_add_f32 v45, v45, v48
    v_mov_b32 v46, s21
    v_mov_b32 v47, s33
    v_mov_b32 v62, v44
    s_waitcnt vmcnt(2)
    buffer_load_dwordx4 v[124:127], v1, s[40:43], s65 offen offset:256 nt
    s_mov_b64 exec, 1
    s_cmp_eq_u32 s20, 1
    s_cbranch_scc1 L_p05_loc
    buffer_store_dwordx4 v[44:47], v7, s[52:55], s10 offen sc1
    s_branch L_p05_pub
L_p05_loc:
    buffer_store_dwordx4 v[44:47], v7, s[52:55], s10 offen
L_p05_pub:
    s_mov_b64 exec, -1
    s_add_u32 s65, s65, 24576
    s_cmp_eq_u32 s65, 196608
    s_cselect_b32 s65, 0, s65
    buffer_load_dwordx4 v[128:131], v1, s[40:43], s65 offen offset:0 nt
    v_cvt_pk_bf16_f32 v24, v24, v24
    v_cvt_pk_bf16_f32 v25, v25, v25
    v_cvt_pk_bf16_f32 v26, v26, v26
    v_cvt_pk_bf16_f32 v27, v27, v27
    v_cvt_pk_bf16_f32 v28, v28, v28
    v_cvt_pk_bf16_f32 v29, v29, v29
    v_sub_f32 v226, 1.0, v56
    v_cvt_pk_bf16_f32 v226, v226, v226
    v_and_b32 v226, 0xffff0000, v226
    v_lshlrev_b32 v208, 4, v0
    v_lshrrev_b32 v58, 4, v0
    v_lshl_add_u32 v209, v58, 3, v6
    v_lshlrev_b32 v214, 4, v209
    s_mul_i32 s3, s32, 1552
    s_add_u32 s3, s3, 12864
    v_add_u32 v209, s3, v214
    s_mul_i32 s3, s32, 512
    s_add_u32 s3, s3, 25280
    v_add_u32 v214, s3, v214
    s_lshr_b32 s3, s32, 2
    s_lshl_b32 s3, s3, 7
    s_and_b32 s34, s32, 3
    s_lshl_b32 s34, s34, 2
    s_add_u32 s3, s3, s34
    s_add_u32 s3, s3, 12864
    v_mul_u32_u24 v210, 1552, v6
    v_add3_u32 v210, v210, v7, s3
    v_lshl_add_u32 v211, v6, 11, v7
    v_and_b32 v59, 15, v0
    v_mul_u32_u24 v212, 2560, v58
    v_lshl_add_u32 v212, v59, 4, v212
    v_mov_b32 v60, 0x80000000
    v_cmp_lt_u32 vcc, 9, v59
    s_nop 1
    v_cndmask_b32 v212, v212, v60, vcc
    v_cmp_lt_u32 vcc, 47, v0
    s_nop 1
    v_cndmask_b32 v213, v212, v60, vcc
    s_mov_b32 s3, 79360
    v_mad_u32_u24 v213, v58, s3, v213
    v_and_b32 v217, 16, v7
    s_lshr_b32 s3, s30, 3
    s_lshl_b32 s3, s3, 5
    v_add_u32 v217, s3, v217
    v_lshrrev_b32 v58, 5, v0
    s_lshl_b32 s3, s32, 1
    v_add_u32 v58, s3, v58
    v_and_b32 v59, 3, v0
    v_mad_u32_u24 v58, v58, 3, v59
    v_bfe_u32 v60, v0, 2, 3
    v_lshrrev_b32 v215, 2, v58
    v_lshlrev_b32 v215, 7, v215
    v_and_b32 v216, 3, v58
    v_lshl_add_u32 v215, v216, 2, v215
    v_lshl_add_u32 v215, v60, 4, v215
    v_add_u32 v215, 25280, v215
    s_lshl_b32 s3, s32, 8
    v_lshl_add_u32 v216, v0, 2, s3
    v_lshl_add_u32 v218, v58, 3, v60
    s_mul_i32 s3, s31, 160
    v_lshl_add_u32 v218, v218, 1, s3
    v_cmp_gt_u32 vcc, 10, v58
    v_cmp_gt_u32 s[66:67], 3, v59
    s_and_b64 s[18:19], vcc, s[66:67]
    v_mov_b32 v227, 0
    v_and_b32 v44, v24, v8
    v_and_b32 v45, v24, v9
    v_and_b32 v46, v24, v10
    v_and_b32 v47, v24, v11
    s_nop 1
    v_mfma_f32_16x16x32_bf16 v[32:35], v[104:107], v[44:47], 0
    v_mfma_f32_16x16x32_bf16 v[36:39], v[108:111], v[44:47], 0
    v_mfma_f32_16x16x32_bf16 v[40:43], v[112:115], v[44:47], 0
    v_and_b32 v48, v25, v8
    v_and_b32 v49, v25, v9
    v_and_b32 v50, v25, v10
    v_and_b32 v51, v25, v11
    s_waitcnt vmcnt(2)
    buffer_load_dwordx4 v[132:135], v1, s[40:43], s65 offen offset:128 nt
    s_waitcnt vmcnt(2)
    buffer_load_dwordx4 v[136:139], v1, s[40:43], s65 offen offset:256 nt
    v_mfma_f32_16x16x32_bf16 v[32:35], v[116:119], v[48:51], v[32:35]
    v_mfma_f32_16x16x32_bf16 v[36:39], v[120:123], v[48:51], v[36:39]
    v_mfma_f32_16x16x32_bf16 v[40:43], v[124:127], v[48:51], v[40:43]
    v_and_b32 v44, v26, v8
    v_and_b32 v45, v26, v9
    v_and_b32 v46, v26, v10
    v_and_b32 v47, v26, v11
    s_add_u32 s65, s65, 24576
    s_cmp_eq_u32 s65, 196608
    s_cselect_b32 s65, 0, s65
    s_waitcnt vmcnt(2)
    buffer_load_dwordx4 v[140:143], v1, s[40:43], s65 offen offset:0 nt
    s_waitcnt vmcnt(2)
    buffer_load_dwordx4 v[144:147], v1, s[40:43], s65 offen offset:128 nt
    s_waitcnt vmcnt(2)
    buffer_load_dwordx4 v[148:151], v1, s[40:43], s65 offen offset:256 nt
    v_mfma_f32_16x16x32_bf16 v[32:35], v[128:131], v[44:47], v[32:35]
    v_mfma_f32_16x16x32_bf16 v[36:39], v[132:135], v[44:47], v[36:39]
    v_mfma_f32_16x16x32_bf16 v[40:43], v[136:139], v[44:47], v[40:43]
    v_and_b32 v48, v27, v8
    v_and_b32 v49, v27, v9
    v_and_b32 v50, v27, v10
    v_and_b32 v51, v27, v11
    buffer_load_dword v228, v227, s[52:55], s15 offen offset:12 sc1
    buffer_load_dwordx4 v[52:55], v217, s[52:55], s22 offen sc1
    s_add_u32 s65, s65, 24576
    s_cmp_eq_u32 s65, 196608
    s_cselect_b32 s65, 0, s65
    s_waitcnt vmcnt(4)
    buffer_load_dwordx4 v[152:155], v1, s[40:43], s65 offen offset:0 nt
    s_waitcnt vmcnt(4)
    buffer_load_dwordx4 v[156:159], v1, s[40:43], s65 offen offset:128 nt
    buffer_load_dwordx4 v[220:223], v208, s[52:55], s11 offen sc1
    s_waitcnt vmcnt(5)
    buffer_load_dwordx4 v[64:67], v1, s[40:43], s65 offen offset:256 nt
    v_mfma_f32_16x16x32_bf16 v[32:35], v[140:143], v[48:51], v[32:35]
    v_mfma_f32_16x16x32_bf16 v[36:39], v[144:147], v[48:51], v[36:39]
    v_mfma_f32_16x16x32_bf16 v[40:43], v[148:151], v[48:51], v[40:43]
    v_and_b32 v44, v28, v8
    v_and_b32 v45, v28, v9
    v_and_b32 v46, v28, v10
    v_and_b32 v47, v28, v11
    s_add_u32 s65, s65, 24576
    s_cmp_eq_u32 s65, 196608
    s_cselect_b32 s65, 0, s65
    s_waitcnt vmcnt(3)
    buffer_load_dwordx4 v[68:71], v1, s[40:43], s65 offen offset:0 nt
    s_waitcnt vmcnt(3)
    buffer_load_dwordx4 v[72:75], v1, s[40:43], s65 offen offset:128 nt
    s_waitcnt vmcnt(2)
    buffer_load_dwordx4 v[76:79], v1, s[40:43], s65 offen offset:256 nt
    v_mfma_f32_16x16x32_bf16 v[32:35], v[152:155], v[44:47], v[32:35]
    v_mfma_f32_16x16x32_bf16 v[36:39], v[156:159], v[44:47], v[36:39]
    v_mfma_f32_16x16x32_bf16 v[40:43], v[64:67], v[44:47], v[40:43]
    v_and_b32 v48, v29, v8
    v_and_b32 v49, v29, v9
    v_and_b32 v50, v29, v10
    v_and_b32 v51, v29, v11
    s_add_u32 s65, s65, 24576
    s_cmp_eq_u32 s65, 196608
    s_cselect_b32 s65, 0, s65
    s_waitcnt vmcnt(2)
    buffer_load_dwordx4 v[80:83], v1, s[40:43], s65 offen offset:0 nt
    s_waitcnt vmcnt(2)
    buffer_load_dwordx4 v[84:87], v1, s[40:43], s65 offen offset:128 nt
    s_waitcnt vmcnt(2)
    buffer_load_dwordx4 v[88:91], v1, s[40:43], s65 offen offset:256 nt
    v_mfma_f32_16x16x32_bf16 v[32:35], v[68:71], v[48:51], v[32:35]
    v_mfma_f32_16x16x32_bf16 v[36:39], v[72:75], v[48:51], v[36:39]
    v_mfma_f32_16x16x32_bf16 v[40:43], v[76:79], v[48:51], v[40:43]
    s_mov_b32 s34, 1048576
L_h05_chk:
    v_cmp_ne_u32 vcc, s33, v223
    v_cmp_ne_u32 s[66:67], s33, v228
    s_or_b64 vcc, vcc, s[66:67]
    v_cmp_ne_u32 s[66:67], s33, v55
    s_or_b64 vcc, vcc, s[66:67]
    s_cbranch_vccz L_h05_ok
    s_mov_b64 exec, vcc
    buffer_load_dwordx4 v[220:223], v208, s[52:55], s11 offen sc1
    buffer_load_dword v228, v227, s[52:55], s15 offen offset:12 sc1
    buffer_load_dwordx4 v[52:55], v217, s[52:55], s22 offen sc1
    s_sub_u32 s34, s34, 1
    s_waitcnt vmcnt(0)
    s_cbranch_scc0 L_h05_chk
L_h05_ok:
    s_mov_b64 exec, -1
    v_cmp_ne_u32 vcc, s21, v222
    s_cmp_eq_u64 vcc, 0
    s_cselect_b32 s20, 1, 0
    s_mov_b32 exec_lo, 0xffff0000
    v_mov_b32 v52, v53
    s_mov_b32 exec_lo, 0
    v_mov_b32 v52, v54
    s_mov_b32 exec_hi, 0xffff0000
    v_mov_b32 v52, 0
    s_mov_b64 exec, -1
    v_and_b32 v55, v52, v11
    v_and_b32 v54, v52, v10
    v_and_b32 v53, v52, v9
    v_and_b32 v52, v52, v8
    v_mov_b32 v224, v220
    s_nop 1
    v_max_f32_dpp v224, v224, v224 quad_perm:[1,0,3,2] row_mask:0xf bank_mask:0xf
    s_nop 1
    v_max_f32_dpp v224, v224, v224 quad_perm:[2,3,0,1] row_mask:0xf bank_mask:0xf
    s_nop 1
    v_max_f32_dpp v224, v224, v224 row_half_mirror row_mask:0xf bank_mask:0xf
    s_nop 1
    v_max_f32_dpp v224, v224, v224 row_ror:8 row_mask:0xf bank_mask:0xf
    v_mov_b32 v225, v224
    s_nop 1
    v_permlane16_swap_b32 v224, v225
    v_max_f32 v224, v224, v225
    v_mov_b32 v225, v224
    s_nop 1
    v_permlane32_swap_b32 v224, v225
    v_max_f32 v224, v224, v225
    v_sub_f32 v220, v220, v224
    v_sub_f32 v62, v62, v224
    v_mul_f32 v220, 0x3fb8aa3b, v220
    v_mul_f32 v62, 0x3fb8aa3b, v62
    v_exp_f32 v220, v220
    v_exp_f32 v62, v62
    v_mul_f32 v220, v220, v221
    s_nop 1
    v_add_f32_dpp v220, v220, v220 quad_perm:[1,0,3,2] row_mask:0xf bank_mask:0xf
    s_nop 1
    v_add_f32_dpp v220, v220, v220 quad_perm:[2,3,0,1] row_mask:0xf bank_mask:0xf
    s_nop 1
    v_add_f32_dpp v220, v220, v220 row_half_mirror row_mask:0xf bank_mask:0xf
    s_nop 1
    v_add_f32_dpp v220, v220, v220 row_ror:8 row_mask:0xf bank_mask:0xf
    v_mov_b32 v225, v220
    s_nop 1
    v_permlane16_swap_b32 v220, v225
    v_add_f32 v220, v220, v225
    v_mov_b32 v225, v220
    s_nop 1
    v_permlane32_swap_b32 v220, v225
    v_add_f32 v220, v220, v225
    v_rcp_f32 v220, v220
    v_mul_f32 v62, v62, v56
    v_mul_f32 v220, v220, v62
    v_mul_f32 v32, v32, v220
    v_mul_f32 v33, v33, v220
    v_mul_f32 v34, v34, v220
    v_mul_f32 v35, v35, v220
    v_mul_f32 v36, v36, v220
    v_mul_f32 v37, v37, v220
    v_mul_f32 v38, v38, v220
    v_mul_f32 v39, v39, v220
    v_mul_f32 v40, v40, v220
    v_mul_f32 v41, v41, v220
    v_mul_f32 v42, v42, v220
    v_mul_f32 v43, v43, v220
    v_mul_f32 v30, v30, v220
    v_mul_f32 v31, v31, v220
    v_cvt_pk_bf16_f32 v30, v30, v30
    v_cvt_pk_bf16_f32 v31, v31, v31
    v_and_b32 v44, v30, v8
    v_and_b32 v45, v30, v9
    v_and_b32 v46, v30, v10
    v_and_b32 v47, v30, v11
    s_add_u32 s65, s65, 24576
    s_cmp_eq_u32 s65, 196608
    s_cselect_b32 s65, 0, s65
    s_waitcnt vmcnt(2)
    buffer_load_dwordx4 v[92:95], v1, s[40:43], s65 offen offset:0 nt
    s_waitcnt vmcnt(2)
    buffer_load_dwordx4 v[96:99], v1, s[40:43], s65 offen offset:128 nt
    s_waitcnt vmcnt(2)
    buffer_load_dwordx4 v[100:103], v1, s[40:43], s65 offen offset:256 nt
    v_mfma_f32_16x16x32_bf16 v[32:35], v[80:83], v[44:47], v[32:35]
    v_mfma_f32_16x16x32_bf16 v[36:39], v[84:87], v[44:47], v[36:39]
    v_mfma_f32_16x16x32_bf16 v[40:43], v[88:91], v[44:47], v[40:43]
    v_and_b32 v48, v31, v8
    v_and_b32 v49, v31, v9
    v_and_b32 v50, v31, v10
    v_and_b32 v51, v31, v11
    s_waitcnt vmcnt(2)
    buffer_load_dwordx4 v[160:163], v213, s[48:51], s17 offen offset:0 nt
    s_waitcnt vmcnt(2)
    buffer_load_dwordx4 v[164:167], v213, s[48:51], s17 offen offset:1280 nt
    s_waitcnt vmcnt(2)
    buffer_load_dwordx4 v[168:171], v212, s[44:47], s16 offen offset:0 nt
    v_mfma_f32_16x16x32_bf16 v[32:35], v[92:95], v[48:51], v[32:35]
    v_mfma_f32_16x16x32_bf16 v[36:39], v[96:99], v[48:51], v[36:39]
    v_mfma_f32_16x16x32_bf16 v[40:43], v[100:103], v[48:51], v[40:43]
    s_mov_b32 exec_lo, 0x00ff00ff
    s_mov_b32 exec_hi, 0xff00ff00
    s_nop 3
    ds_write_b128 v209, v[32:35] offset:0
    ds_write_b128 v209, v[36:39] offset:512
    ds_write_b128 v209, v[40:43] offset:1024
    s_mov_b64 exec, -1
    buffer_load_dwordx4 v[172:175], v212, s[44:47], s16 offen offset:1280 nt
    s_add_u32 s16, s16, 81920
    buffer_load_dwordx4 v[176:179], v212, s[44:47], s16 offen offset:0 nt
    s_waitcnt lgkmcnt(0)
    s_barrier
    ds_read2st64_b32 v[12:13], v210 offset0:0 offset1:1
    ds_read2st64_b32 v[14:15], v210 offset0:2 offset1:3
    ds_read2st64_b32 v[16:17], v210 offset0:4 offset1:5
    v_mov_b32 v47, s9
    s_waitcnt lgkmcnt(0)
    v_add_f32 v44, v12, v13
    v_add_f32 v45, v14, v15
    v_add_f32 v46, v16, v17
    v_add_f32_dpp v44, v44, v44 quad_perm:[1,0,3,2] row_mask:0xf bank_mask:0xf
    v_add_f32_dpp v45, v45, v45 quad_perm:[1,0,3,2] row_mask:0xf bank_mask:0xf
    v_add_f32_dpp v46, v46, v46 quad_perm:[1,0,3,2] row_mask:0xf bank_mask:0xf
    v_add_f32_dpp v44, v44, v44 quad_perm:[2,3,0,1] row_mask:0xf bank_mask:0xf
    v_add_f32_dpp v45, v45, v45 quad_perm:[2,3,0,1] row_mask:0xf bank_mask:0xf
    v_add_f32_dpp v46, v46, v46 quad_perm:[2,3,0,1] row_mask:0xf bank_mask:0xf
    v_add_f32_dpp v44, v44, v44 row_half_mirror row_mask:0xf bank_mask:0xf
    v_add_f32_dpp v45, v45, v45 row_half_mirror row_mask:0xf bank_mask:0xf
    v_add_f32_dpp v46, v46, v46 row_half_mirror row_mask:0xf bank_mask:0xf
    s_mov_b64 exec, s[68:69]
    s_cmp_eq_u32 s20, 1
    s_cbranch_scc1 L_p1_loc
    buffer_store_dwordx4 v[44:47], v7, s[52:55], s12 offen sc1
    s_branch L_p1_pub
L_p1_loc:
    buffer_store_dwordx4 v[44:47], v7, s[52:55], s12 offen
L_p1_pub:
    s_mov_b64 exec, -1
    buffer_load_dwordx4 v[48:51], v211, s[52:55], s13 offen sc1
    buffer_load_dwordx4 v[180:183], v212, s[44:47], s16 offen offset:1280 nt
    s_add_u32 s16, s16, 81920
    buffer_load_dwordx4 v[184:187], v212, s[44:47], s16 offen offset:0 nt
    buffer_load_dwordx4 v[188:191], v212, s[44:47], s16 offen offset:1280 nt
    s_waitcnt vmcnt(7)
    v_mfma_f32_16x16x32_bf16 v[200:203], v[160:163], v[52:55], 0
    v_mfma_f32_16x16x32_bf16 v[204:207], v[164:167], v[52:55], 0
    s_nop 6
    v_mul_f32 v200, v200, v226
    v_mul_f32 v201, v201, v226
    v_mul_f32 v202, v202, v226
    v_mul_f32 v203, v203, v226
    v_mul_f32 v204, v204, v226
    v_mul_f32 v205, v205, v226
    v_mul_f32 v206, v206, v226
    v_mul_f32 v207, v207, v226
    s_mov_b32 s34, 1048576
    s_waitcnt vmcnt(3)
L_h1_chk:
    v_cmp_ne_u32 vcc, s9, v51
    s_cbranch_vccz L_h1_ok
    s_mov_b64 exec, vcc
    buffer_load_dwordx4 v[48:51], v211, s[52:55], s13 offen sc1
    s_sub_u32 s34, s34, 1
    s_waitcnt vmcnt(0)
    s_cbranch_scc0 L_h1_chk
L_h1_ok:
    s_mov_b64 exec, -1
    v_add_f32_dpp v48, v48, v48 quad_perm:[1,0,3,2] row_mask:0xf bank_mask:0xf
    v_add_f32_dpp v49, v49, v49 quad_perm:[1,0,3,2] row_mask:0xf bank_mask:0xf
    v_add_f32_dpp v50, v50, v50 quad_perm:[1,0,3,2] row_mask:0xf bank_mask:0xf
    v_add_f32_dpp v48, v48, v48 quad_perm:[2,3,0,1] row_mask:0xf bank_mask:0xf
    v_add_f32_dpp v49, v49, v49 quad_perm:[2,3,0,1] row_mask:0xf bank_mask:0xf
    v_add_f32_dpp v50, v50, v50 quad_perm:[2,3,0,1] row_mask:0xf bank_mask:0xf
    v_add_f32_dpp v48, v48, v48 row_half_mirror row_mask:0xf bank_mask:0xf
    v_add_f32_dpp v49, v49, v49 row_half_mirror row_mask:0xf bank_mask:0xf
    v_add_f32_dpp v50, v50, v50 row_half_mirror row_mask:0xf bank_mask:0xf
    v_cvt_pk_bf16_f32 v48, v48, v48
    v_cvt_pk_bf16_f32 v49, v49, v49
    v_cvt_pk_bf16_f32 v50, v50, v50
    v_and_b32 v12, v48, v8
    v_and_b32 v13, v48, v9
    v_and_b32 v14, v48, v10
    v_and_b32 v15, v48, v11
    v_and_b32 v16, v49, v8
    v_and_b32 v17, v49, v9
    v_mfma_f32_16x16x32_bf16 v[200:203], v[168:171], v[12:15], v[200:203]
    v_and_b32 v18, v49, v10
    v_and_b32 v19, v49, v11
    v_mfma_f32_16x16x32_bf16 v[204:207], v[172:175], v[12:15], v[204:207]
    v_and_b32 v20, v50, v8
    v_and_b32 v21, v50, v9
    v_mfma_f32_16x16x32_bf16 v[200:203], v[176:179], v[16:19], v[200:203]
    v_and_b32 v22, v50, v10
    v_and_b32 v23, v50, v11
    s_waitcnt vmcnt(2)
    v_mfma_f32_16x16x32_bf16 v[204:207], v[180:183], v[16:19], v[204:207]
    s_waitcnt vmcnt(1)
    v_mfma_f32_16x16x32_bf16 v[200:203], v[184:187], v[20:23], v[200:203]
    s_waitcnt vmcnt(0)
    v_mfma_f32_16x16x32_bf16 v[204:207], v[188:191], v[20:23], v[204:207]
    s_nop 7
    v_add_f32_dpp v200, v204, v200 row_ror:8 row_mask:0xf bank_mask:0xf
    v_add_f32_dpp v201, v205, v201 row_ror:8 row_mask:0xf bank_mask:0xf
    v_add_f32_dpp v202, v206, v202 row_ror:8 row_mask:0xf bank_mask:0xf
    v_add_f32_dpp v203, v207, v203 row_ror:8 row_mask:0xf bank_mask:0xf
    s_mov_b32 exec_lo, 0x00ff00ff
    s_mov_b32 exec_hi, 0x000000ff
    ds_write_b128 v214, v[200:203]
    s_mov_b64 exec, -1
    s_cmp_lt_u32 s32, 2
    s_waitcnt lgkmcnt(0)
    s_barrier
    s_cbranch_scc0 L_done
    ds_read2st64_b32 v[64:65], v215 offset0:0 offset1:2
    ds_read2st64_b32 v[66:67], v215 offset0:4 offset1:6
    ds_read2st64_b32 v[68:69], v215 offset0:8 offset1:10
    ds_read2st64_b32 v[70:71], v215 offset0:12 offset1:14
    v_mov_b32 v72, 1.0
    s_waitcnt lgkmcnt(0)
    v_add_f32 v64, v64, v65
    v_add_f32 v66, v66, v67
    v_add_f32 v68, v68, v69
    v_add_f32 v70, v70, v71
    v_add_f32 v64, v64, v66
    v_add_f32 v68, v68, v70
    v_add_f32 v64, v64, v68
    v_cndmask_b32 v72, v72, v64, s[18:19]
    buffer_atomic_add_f32 v72, v216, s[52:55], s14 offen sc0 sc1
    s_waitcnt vmcnt(0)
    v_add_f32 v64, v64, v72
    v_mov_b32_dpp v65, v72 quad_perm:[3,3,3,3] row_mask:0xf bank_mask:0xf
    v_cmp_eq_f32 vcc, 0x41f80000, v65
    v_cvt_pk_bf16_f32 v64, v64, v64
    s_and_b64 exec, vcc, s[18:19]
    s_cbranch_execz L_done
    buffer_store_short v64, v218, s[56:59], 0 offen
    s_or_b32 s3, s31, s32
    s_cmp_eq_u32 s3, 0
    s_cbranch_scc0 L_done
    s_and_b64 exec, exec, 1
    s_cbranch_execz L_done
    v_mov_b32 v44, s9
    buffer_store_dword v44, v227, s[52:55], 0 offen
L_done:
L_end:
    s_endpgm
.fill 64, 4, 0xbf800000
.section .rodata,"a"
.p2align 6
.amdhsa_kernel gated_mix__sliding_block_cached__geglu_ffn__decode_kernel
  .amdhsa_next_free_vgpr 256
  .amdhsa_next_free_sgpr 102
  .amdhsa_accum_offset 256
  .amdhsa_group_segment_fixed_size 0
  .amdhsa_kernarg_size 104
  .amdhsa_user_sgpr_count 2
  .amdhsa_user_sgpr_kernarg_segment_ptr 1
  .amdhsa_system_sgpr_workgroup_id_x 1
  .amdhsa_float_denorm_mode_32 3
.end_amdhsa_kernel
```
